```python
import torch

def _softmax(x, axis=-1):
    return torch.softmax(x, dim=axis)
def _gelu(x):
    return torch.nn.functional.gelu(x, approximate="tanh")
def _silu(x):
    return torch.nn.functional.silu(x)
def _sigmoid(x):
    return torch.sigmoid(x)
def _layernorm(x, axis=-1, eps=1e-5):
    m = x.mean(dim=axis, keepdim=True)
    v = x.var(dim=axis, keepdim=True, unbiased=False)
    return (x - m) / torch.sqrt(v + eps)
def _scatter_add(tgt, idx, src, axis=0):
    return tgt.clone().index_add_(axis, idx, src)
def _segment_sum(src, seg, n):
    out = torch.zeros((n,) + src.shape[1:], dtype=src.dtype)
    return out.index_add_(0, seg, src)
def _pad(x, pw):
    flat = tuple(v for pair in reversed(pw) for v in pair)
    return torch.nn.functional.pad(x, flat)

kernel_name = 'standalone__glu_gated_swiglu__sampling'

def setup_inputs():

    _w = (lambda a: (lambda t: t.to(torch.bfloat16) if t.is_floating_point() else t)(torch.as_tensor(a)))
    B, S, D, F = 32, 32, 512, 1792
    return {
        "x": _w((lambda *s: torch.randn(*s, dtype=torch.bfloat16) * 0.05)(B, S, D)),
        "w1": _w((lambda *s: torch.randn(*s, dtype=torch.bfloat16) * 0.05)(D, F) * (2.0 / D) ** 0.5),
        "w3": _w((lambda *s: torch.randn(*s, dtype=torch.bfloat16) * 0.05)(D, F) * (2.0 / D) ** 0.5),
        "w2": _w((lambda *s: torch.randn(*s, dtype=torch.bfloat16) * 0.05)(F, D) * (2.0 / F) ** 0.5),
    }

def reference(x, w1, w3, w2):
    gate = torch.einsum("bsd,df->bsf", x, w1)
    up = torch.einsum("bsd,df->bsf", x, w3)
    h = _silu(gate) * up
    out = torch.einsum("bsf,fd->bsd", h, w2)
    return out
```

```asm
; @launch grid=(256,1,1) block=(512,1,1) lds=163840
.amdgcn_target "amdgcn-amd-amdhsa--gfx950"
.text
.globl standalone__glu_gated_swiglu__sampling_kernel
.p2align 10
.p2align 8
.type standalone__glu_gated_swiglu__sampling_kernel,@function
standalone__glu_gated_swiglu__sampling_kernel:
  s_load_dwordx2 s[20:21], s[0:1], 0
  s_load_dwordx2 s[24:25], s[0:1], 8
  s_load_dwordx2 s[28:29], s[0:1], 16
  s_load_dwordx2 s[14:15], s[0:1], 40
  s_load_dwordx2 s[32:33], s[0:1], 24
  s_load_dwordx2 s[40:41], s[0:1], 32
  s_load_dwordx2 s[36:37], s[0:1], 48
  s_memrealtime s[8:9]
  s_cmp_ge_u32 s2, 256
  s_cbranch_scc1 L_end
  s_getpc_b64 s[96:97]
L_pc:
  s_lshr_b32 s19, s2, 3
  s_mul_i32 s98, s19, 3
  v_add_u32 v5, s98, v0
  v_min_u32 v5, (L_end-standalone__glu_gated_swiglu__sampling_kernel)>>7, v5
  v_lshlrev_b32 v5, 7, v5
  s_sub_u32 s96, s96, L_pc-standalone__glu_gated_swiglu__sampling_kernel
  s_subb_u32 s97, s97, 0
  v_mov_b32 v7, s97
  v_add_co_u32 v6, vcc, s96, v5
  v_addc_co_u32 v7, vcc, 0, v7, vcc
  v_cmp_gt_u32 vcc, 3, v0
  s_and_saveexec_b64 s[98:99], vcc
  s_cbranch_execz L_cpf_skip
  global_load_dword v253, v[6:7], off
L_cpf_skip:
  s_mov_b64 exec, s[98:99]
  v_lshrrev_b32 v1, 6, v0
  v_and_b32 v2, 63, v0
  v_readfirstlane_b32 s44, v1
  s_and_b32 s18, s2, 7
  s_lshr_b32 s19, s2, 3
  s_and_b32 s56, s18, 1
  s_lshr_b32 s57, s18, 1
  s_and_b32 s16, s19, 3
  s_lshr_b32 s17, s19, 2
  s_lshl_b32 s45, s56, 2
  s_add_u32 s45, s45, s16
  s_mov_b32 s5, s45
  s_mul_i32 s46, s57, 7
  s_add_u32 s46, s46, s17
  s_lshl_b32 s50, s16, 1
  s_add_u32 s50, s50, s17
  s_and_b32 s50, s50, 7
  s_lshl_b32 s3, s57, 3
  s_add_u32 s3, s3, s17
  s_mov_b32 s22, 0x100000
  s_mov_b32 s23, 0x20000
  s_mov_b32 s26, 1835008
  s_mov_b32 s27, 0x20000
  s_mov_b32 s30, 1835008
  s_mov_b32 s31, 0x20000
  s_mov_b32 s34, 1835008
  s_mov_b32 s35, 0x20000
  s_mov_b32 s38, 0x800000
  s_mov_b32 s39, 0x20000
  s_mov_b32 s42, 0x100000
  s_mov_b32 s43, 0x20000
  s_and_b32 s47, s44, 3
  s_cmp_lt_u32 s19, 28
  s_cselect_b32 s48, 1, 0
  v_lshrrev_b32 v3, 3, v2
  v_and_b32 v4, 7, v2
  s_cmp_lt_u32 s44, 4
  s_cbranch_scc1 L_compute
  v_lshrrev_b32 v13, 1, v3
  v_xor_b32 v14, v4, v13
  v_xor_b32 v15, 4, v14
  s_lshl_b32 s56, s47, 15
  v_lshlrev_b32 v26, 10, v3
  v_add_u32 v26, s56, v26
  v_lshl_add_u32 v16, v14, 4, v26
  v_lshl_add_u32 v17, v15, 4, v26
  v_add_u32 v17, 7168, v17
  v_add_u32 v18, 14336, v16
  v_add_u32 v19, 14336, v17
  v_and_b32 v13, 1, v13
  v_lshlrev_b32 v13, 2, v13
  v_xor_b32 v13, v4, v13
  s_movk_i32 s57, 3584
  s_lshl_b32 s56, s47, 4
  v_add_u32 v27, s56, v3
  v_mul_lo_u32 v27, v27, s57
  v_lshl_add_u32 v20, v13, 4, v27
  v_add_u32 v21, 27648, v20
  s_lshl_b32 s53, s45, 17
  s_lshl_b32 s54, s46, 7
  s_lshl_b32 s49, s47, 12
  s_mov_b32 s55, 0
  s_xor_b32 s56, s44, 4
  s_or_b32 s56, s56, s2
  s_cmp_eq_u32 s56, 0
  s_waitcnt lgkmcnt(0)
  s_cbranch_scc0 L_ld_npub
  s_or_b32 s8, s8, 1
  v_mov_b32 v5, 0
  v_mov_b32 v8, s8
  v_mov_b32 v9, s9
  s_mov_b64 exec, 1
  global_store_dwordx2 v5, v[8:9], s[14:15] sc1
  s_mov_b64 exec, -1
L_ld_npub:
  s_cmp_eq_u32 s48, 1
  s_cbranch_scc0 L_ld_inact
  s_mov_b32 s6, s50
  s_mov_b32 s7, 16384
  s_mov_b32 s58, 0
  s_mov_b32 s10, 989
  s_mov_b32 s11, 1003
  s_mov_b32 s16, 1956
L_ld_loop:
  s_bitcmp1_b32 s10, s58
  s_cbranch_scc0 L_ld_nx
  s_lshl_b32 s56, s50, 7
  s_add_u32 s51, s53, s56
  s_add_u32 m0, s55, s49
  s_add_u32 s50, s50, 1
  buffer_load_dwordx4 v16, s[20:23], s51 offen lds
  buffer_load_dwordx4 v17, s[20:23], s51 offen offset:1024 lds
  buffer_load_dwordx4 v18, s[20:23], s51 offen offset:2048 lds
  buffer_load_dwordx4 v19, s[20:23], s51 offen offset:3072 lds
  s_and_b32 s50, s50, 7
  s_add_u32 s55, s55, 32768
  s_and_b32 s55, s55, 0x1ffff
L_ld_nx:
  s_bitcmp1_b32 s11, s58
  s_cbranch_scc0 L_ld_nw
  s_mul_i32 s56, s6, 229376
  s_add_u32 s52, s54, s56
  s_add_u32 m0, s7, s49
  s_add_u32 s6, s6, 1
  buffer_load_dwordx4 v20, s[24:27], s52 offen lds
  buffer_load_dwordx4 v21, s[24:27], s52 offen offset:1024 lds
  s_add_u32 m0, m0, 2048
  s_and_b32 s6, s6, 7
  buffer_load_dwordx4 v20, s[28:31], s52 offen lds
  buffer_load_dwordx4 v21, s[28:31], s52 offen offset:1024 lds
  s_add_u32 s7, s7, 32768
  s_and_b32 s7, s7, 0x1ffff
L_ld_nw:
  s_add_u32 s58, s58, 1
  s_bitcmp1_b32 s16, s58
  s_cbranch_scc0 L_ld_loop
  s_cmp_lt_u32 s58, 6
  s_cbranch_scc0 L_ld_w
  s_cmp_eq_u32 s58, 2
  s_cbranch_scc0 L_ld_w1
  s_waitcnt vmcnt(4)
L_ld_w1:
  s_waitcnt vmcnt(12)
L_ld_w:
  s_waitcnt vmcnt(16)
  s_barrier
  s_lshl_b32 s56, s47, 8
  s_or_b32 s56, s56, s58
  s_cmp_eq_u32 s56, 7
  s_cbranch_scc0 L_ld_nep
  s_load_dwordx2 s[8:9], s[14:15], 0
L_ld_nep:
  s_cmp_lg_u32 s58, 10
  s_cbranch_scc1 L_ld_loop
  v_lshrrev_b32 v5, 1, v3
  v_and_b32 v5, 1, v5
  v_lshlrev_b32 v5, 2, v5
  v_lshrrev_b32 v6, 2, v3
  v_lshlrev_b32 v6, 1, v6
  v_xor_b32 v5, v5, v6
  v_xor_b32 v5, v4, v5
  v_lshlrev_b32 v6, 10, v3
  v_lshl_add_u32 v22, v5, 4, v6
  v_add_u32 v23, 7168, v22
  v_add_u32 v24, 14336, v22
  v_add_u32 v25, 21504, v22
  s_mul_i32 s56, s47, 458752
  s_lshl_b32 s57, s5, 7
  s_add_u32 s59, s56, s57
  s_add_u32 s13, s59, 262144
  s_lshl_b32 s63, s47, 13
  s_add_u32 m0, s49, 131072
  s_nop 0
  buffer_load_dwordx4 v22, s[32:35], s59 offen lds
  buffer_load_dwordx4 v23, s[32:35], s59 offen offset:1024 lds
  buffer_load_dwordx4 v24, s[32:35], s59 offen offset:2048 lds
  buffer_load_dwordx4 v25, s[32:35], s59 offen offset:3072 lds
  s_add_u32 s59, s59, 32768
  v_lshrrev_b32 v5, 4, v2
  v_bfe_u32 v6, v2, 2, 2
  v_and_b32 v7, 3, v2
  v_lshrrev_b32 v8, 1, v5
  v_lshlrev_b32 v8, 4, v8
  v_and_b32 v9, 1, v5
  v_lshl_add_u32 v8, v9, 2, v8
  v_add_u32 v8, v8, v6
  v_lshlrev_b32 v8, 7, v8
  v_lshrrev_b32 v5, 1, v7
  v_lshrrev_b32 v6, 1, v6
  v_lshl_add_u32 v5, v6, 2, v5
  v_lshlrev_b32 v9, 1, v9
  v_xor_b32 v5, v5, v9
  v_lshl_add_u32 v8, v5, 4, v8
  v_and_b32 v7, 1, v7
  v_lshl_add_u32 v28, v7, 3, v8
  v_xor_b32 v29, 32, v28
  v_xor_b32 v30, 64, v28
  v_xor_b32 v31, 96, v28
  s_add_u32 s56, s49, 131072
  v_add_u32 v10, s56, v28
  v_add_u32 v11, s56, v29
  v_add_u32 v12, s56, v30
  v_add_u32 v13, s56, v31
  v_add_u32 v28, s63, v28
  v_add_u32 v29, s63, v29
  v_add_u32 v30, s63, v30
  v_add_u32 v31, s63, v31
  v_add_u32 v16, 65536, v28
  v_add_u32 v17, 65536, v29
  v_add_u32 v18, 65536, v30
  v_add_u32 v19, 65536, v31
  v_lshrrev_b32 v5, 5, v2
  v_bfe_u32 v6, v2, 4, 1
  v_and_b32 v7, 15, v2
  v_lshlrev_b32 v5, 10, v5
  v_lshl_add_u32 v5, v6, 9, v5
  v_lshl_add_u32 v5, v7, 4, v5
  s_and_b32 s56, s3, 1
  s_lshl_b32 s56, s56, 8
  v_add_u32 v14, s56, v5
  s_mul_i32 s56, s47, 14
  s_add_u32 s56, s56, 0
  s_lshr_b32 s57, s3, 1
  s_mul_i32 s57, s57, 112
  s_add_u32 s57, s57, s56
  s_lshl_b32 s60, s57, 11
  s_lshr_b32 s56, s3, 1
  s_mul_i32 s56, s56, 56
  s_mul_i32 s57, s47, 14
  s_add_u32 s56, s56, s57
  s_lshl_b32 s56, s56, 7
  s_add_u32 s61, s56, 4194304
  v_lshlrev_b32 v15, 7, v2
  s_waitcnt vmcnt(12)
  s_barrier
  s_add_u32 m0, s63, 0
  s_nop 0
  buffer_load_dwordx4 v22, s[32:35], s59 offen lds
  buffer_load_dwordx4 v23, s[32:35], s59 offen offset:1024 lds
  buffer_load_dwordx4 v24, s[32:35], s59 offen offset:2048 lds
  buffer_load_dwordx4 v25, s[32:35], s59 offen offset:3072 lds
  s_add_u32 s59, s59, 32768
  s_waitcnt vmcnt(8)
  s_cmp_eq_u32 s47, 0
  s_cbranch_scc0 L_ld_nf7
  s_waitcnt lgkmcnt(0)
  s_or_b32 s56, s8, s9
  s_cmp_lg_u32 s56, 0
  s_cbranch_scc1 L_ep_ok0
  s_mov_b32 s62, 400000
  v_mov_b32 v5, 0
L_ep_retry0:
  global_load_dwordx2 v[8:9], v5, s[14:15] sc1
  s_sub_u32 s62, s62, 1
  s_cmp_eq_u32 s62, 0
  s_waitcnt vmcnt(0)
  v_readfirstlane_b32 s8, v8
  v_readfirstlane_b32 s9, v9
  s_cbranch_scc1 L_ep_ok0
  s_or_b32 s56, s8, s9
  s_cmp_eq_u32 s56, 0
  s_cbranch_scc1 L_ep_retry0
L_ep_ok0:
  v_mov_b32 v5, 147456
  v_mov_b32 v8, s8
  v_mov_b32 v9, s9
  ds_write_b64 v5, v[8:9]
  s_waitcnt lgkmcnt(0)
L_ld_nf7:
  s_barrier
  s_branch L_ld_p2
L_ld_inact:
  s_lshl_b32 s56, s47, 5
  v_add_u32 v5, s56, v2
  v_lshlrev_b32 v5, 10, v5
  s_lshl_b32 s56, s50, 7
  s_add_u32 s51, s53, s56
  s_mov_b32 exec_hi, 0
  buffer_load_dword v253, v5, s[20:23], s51 offen
  s_mov_b32 exec_hi, -1
  v_lshrrev_b32 v5, 2, v2
  v_and_b32 v6, 3, v2
  v_lshlrev_b32 v5, 10, v5
  v_lshl_add_u32 v5, v6, 7, v5
  s_and_b32 s56, s45, 3
  s_mul_i32 s56, s56, 458752
  s_lshl_b32 s57, s47, 14
  s_add_u32 s56, s56, s57
  s_lshr_b32 s57, s45, 2
  s_lshl_b32 s57, s57, 9
  s_add_u32 s52, s56, s57
  s_lshr_b32 s58, s3, 3
  s_lshl_b32 s58, s58, 17
  s_add_u32 s56, s52, s58
  buffer_load_dword v253, v5, s[32:35], s56 offen
  s_add_u32 s58, s58, 65536
  s_cmp_eq_u32 s58, 458752
  s_cselect_b32 s58, 0, s58
  s_add_u32 s56, s52, s58
  buffer_load_dword v253, v5, s[32:35], s56 offen
  s_add_u32 s58, s58, 65536
  s_cmp_eq_u32 s58, 458752
  s_cselect_b32 s58, 0, s58
  s_waitcnt vmcnt(1)
  s_add_u32 s56, s52, s58
  buffer_load_dword v253, v5, s[32:35], s56 offen
  s_add_u32 s58, s58, 65536
  s_cmp_eq_u32 s58, 458752
  s_cselect_b32 s58, 0, s58
  s_waitcnt vmcnt(1)
  s_add_u32 s56, s52, s58
  buffer_load_dword v253, v5, s[32:35], s56 offen
  s_add_u32 s58, s58, 65536
  s_cmp_eq_u32 s58, 458752
  s_cselect_b32 s58, 0, s58
  s_waitcnt vmcnt(1)
  s_add_u32 s56, s52, s58
  buffer_load_dword v253, v5, s[32:35], s56 offen
  s_add_u32 s58, s58, 65536
  s_cmp_eq_u32 s58, 458752
  s_cselect_b32 s58, 0, s58
  s_waitcnt vmcnt(1)
  s_add_u32 s56, s52, s58
  buffer_load_dword v253, v5, s[32:35], s56 offen
  s_add_u32 s58, s58, 65536
  s_cmp_eq_u32 s58, 458752
  s_cselect_b32 s58, 0, s58
  s_waitcnt vmcnt(1)
  s_add_u32 s56, s52, s58
  buffer_load_dword v253, v5, s[32:35], s56 offen
  s_add_u32 s58, s58, 65536
  s_cmp_eq_u32 s58, 458752
  s_cselect_b32 s58, 0, s58
  v_lshrrev_b32 v5, 1, v3
  v_and_b32 v5, 1, v5
  v_lshlrev_b32 v5, 2, v5
  v_lshrrev_b32 v6, 2, v3
  v_lshlrev_b32 v6, 1, v6
  v_xor_b32 v5, v5, v6
  v_xor_b32 v5, v4, v5
  v_lshlrev_b32 v6, 10, v3
  v_lshl_add_u32 v22, v5, 4, v6
  v_add_u32 v23, 7168, v22
  v_add_u32 v24, 14336, v22
  v_add_u32 v25, 21504, v22
  s_mul_i32 s56, s47, 458752
  s_lshl_b32 s57, s5, 7
  s_add_u32 s59, s56, s57
  s_add_u32 s13, s59, 262144
  s_lshl_b32 s63, s47, 13
  s_add_u32 m0, s49, 131072
  s_nop 0
  buffer_load_dwordx4 v22, s[32:35], s59 offen lds
  buffer_load_dwordx4 v23, s[32:35], s59 offen offset:1024 lds
  buffer_load_dwordx4 v24, s[32:35], s59 offen offset:2048 lds
  buffer_load_dwordx4 v25, s[32:35], s59 offen offset:3072 lds
  s_add_u32 s59, s59, 32768
  s_add_u32 m0, s63, 0
  s_nop 0
  buffer_load_dwordx4 v22, s[32:35], s59 offen lds
  buffer_load_dwordx4 v23, s[32:35], s59 offen offset:1024 lds
  buffer_load_dwordx4 v24, s[32:35], s59 offen offset:2048 lds
  buffer_load_dwordx4 v25, s[32:35], s59 offen offset:3072 lds
  s_add_u32 s59, s59, 32768
  v_lshrrev_b32 v5, 4, v2
  v_bfe_u32 v6, v2, 2, 2
  v_and_b32 v7, 3, v2
  v_lshrrev_b32 v8, 1, v5
  v_lshlrev_b32 v8, 4, v8
  v_and_b32 v9, 1, v5
  v_lshl_add_u32 v8, v9, 2, v8
  v_add_u32 v8, v8, v6
  v_lshlrev_b32 v8, 7, v8
  v_lshrrev_b32 v5, 1, v7
  v_lshrrev_b32 v6, 1, v6
  v_lshl_add_u32 v5, v6, 2, v5
  v_lshlrev_b32 v9, 1, v9
  v_xor_b32 v5, v5, v9
  v_lshl_add_u32 v8, v5, 4, v8
  v_and_b32 v7, 1, v7
  v_lshl_add_u32 v28, v7, 3, v8
  v_xor_b32 v29, 32, v28
  v_xor_b32 v30, 64, v28
  v_xor_b32 v31, 96, v28
  s_add_u32 s56, s49, 131072
  v_add_u32 v10, s56, v28
  v_add_u32 v11, s56, v29
  v_add_u32 v12, s56, v30
  v_add_u32 v13, s56, v31
  v_add_u32 v28, s63, v28
  v_add_u32 v29, s63, v29
  v_add_u32 v30, s63, v30
  v_add_u32 v31, s63, v31
  v_add_u32 v16, 65536, v28
  v_add_u32 v17, 65536, v29
  v_add_u32 v18, 65536, v30
  v_add_u32 v19, 65536, v31
  v_lshrrev_b32 v5, 5, v2
  v_bfe_u32 v6, v2, 4, 1
  v_and_b32 v7, 15, v2
  v_lshlrev_b32 v5, 10, v5
  v_lshl_add_u32 v5, v6, 9, v5
  v_lshl_add_u32 v5, v7, 4, v5
  s_and_b32 s56, s3, 1
  s_lshl_b32 s56, s56, 8
  v_add_u32 v14, s56, v5
  s_mul_i32 s56, s47, 14
  s_add_u32 s56, s56, 0
  s_lshr_b32 s57, s3, 1
  s_mul_i32 s57, s57, 112
  s_add_u32 s57, s57, s56
  s_lshl_b32 s60, s57, 11
  s_lshr_b32 s56, s3, 1
  s_mul_i32 s56, s56, 56
  s_mul_i32 s57, s47, 14
  s_add_u32 s56, s56, s57
  s_lshl_b32 s56, s56, 7
  s_add_u32 s61, s56, 4194304
  v_lshlrev_b32 v15, 7, v2
L_ld_p2:
  s_add_u32 m0, s63, 4096
  s_nop 0
  buffer_load_dwordx4 v22, s[32:35], s59 offen lds
  buffer_load_dwordx4 v23, s[32:35], s59 offen offset:1024 lds
  buffer_load_dwordx4 v24, s[32:35], s59 offen offset:2048 lds
  buffer_load_dwordx4 v25, s[32:35], s59 offen offset:3072 lds
  s_add_u32 s59, s59, 32768
  s_add_u32 m0, s63, 32768
  s_nop 0
  buffer_load_dwordx4 v22, s[32:35], s13 offen lds
  buffer_load_dwordx4 v23, s[32:35], s13 offen offset:1024 lds
  buffer_load_dwordx4 v24, s[32:35], s13 offen offset:2048 lds
  buffer_load_dwordx4 v25, s[32:35], s13 offen offset:3072 lds
  s_add_u32 s13, s13, 32768
  s_add_u32 m0, s63, 36864
  s_nop 0
  buffer_load_dwordx4 v22, s[32:35], s13 offen lds
  buffer_load_dwordx4 v23, s[32:35], s13 offen offset:1024 lds
  buffer_load_dwordx4 v24, s[32:35], s13 offen offset:2048 lds
  buffer_load_dwordx4 v25, s[32:35], s13 offen offset:3072 lds
  s_add_u32 s13, s13, 32768
  s_add_u32 m0, s63, 65536
  s_nop 0
  buffer_load_dwordx4 v22, s[32:35], s59 offen lds
  buffer_load_dwordx4 v23, s[32:35], s59 offen offset:1024 lds
  buffer_load_dwordx4 v24, s[32:35], s59 offen offset:2048 lds
  buffer_load_dwordx4 v25, s[32:35], s59 offen offset:3072 lds
  s_add_u32 s59, s59, 32768
  s_waitcnt vmcnt(20)
  ds_read_b64_tr_b16 v[128:129], v10 offset:0
  ds_read_b64_tr_b16 v[130:131], v10 offset:1024
  ds_read_b64_tr_b16 v[132:133], v11 offset:0
  ds_read_b64_tr_b16 v[134:135], v11 offset:1024
  ds_read_b64_tr_b16 v[136:137], v12 offset:0
  ds_read_b64_tr_b16 v[138:139], v12 offset:1024
  ds_read_b64_tr_b16 v[140:141], v13 offset:0
  ds_read_b64_tr_b16 v[142:143], v13 offset:1024
  s_waitcnt vmcnt(16)
  s_waitcnt lgkmcnt(0)
  ds_read_b64_tr_b16 v[144:145], v28 offset:0
  ds_read_b64_tr_b16 v[146:147], v28 offset:1024
  ds_read_b64_tr_b16 v[148:149], v29 offset:0
  ds_read_b64_tr_b16 v[150:151], v29 offset:1024
  ds_read_b64_tr_b16 v[152:153], v30 offset:0
  ds_read_b64_tr_b16 v[154:155], v30 offset:1024
  ds_read_b64_tr_b16 v[156:157], v31 offset:0
  ds_read_b64_tr_b16 v[158:159], v31 offset:1024
  s_waitcnt vmcnt(12)
  s_waitcnt lgkmcnt(0)
  ds_read_b64_tr_b16 v[160:161], v28 offset:4096
  ds_read_b64_tr_b16 v[162:163], v28 offset:5120
  ds_read_b64_tr_b16 v[164:165], v29 offset:4096
  ds_read_b64_tr_b16 v[166:167], v29 offset:5120
  ds_read_b64_tr_b16 v[168:169], v30 offset:4096
  ds_read_b64_tr_b16 v[170:171], v30 offset:5120
  ds_read_b64_tr_b16 v[172:173], v31 offset:4096
  ds_read_b64_tr_b16 v[174:175], v31 offset:5120
  s_waitcnt vmcnt(0)
  s_waitcnt lgkmcnt(0)
  ds_read_b64_tr_b16 v[176:177], v16 offset:0
  ds_read_b64_tr_b16 v[178:179], v16 offset:1024
  ds_read_b64_tr_b16 v[180:181], v17 offset:0
  ds_read_b64_tr_b16 v[182:183], v17 offset:1024
  ds_read_b64_tr_b16 v[184:185], v18 offset:0
  ds_read_b64_tr_b16 v[186:187], v18 offset:1024
  ds_read_b64_tr_b16 v[188:189], v19 offset:0
  ds_read_b64_tr_b16 v[190:191], v19 offset:1024
  s_cmp_eq_u32 s48, 1
  s_cbranch_scc0 L_ld_nbs
  s_barrier
L_ld_nbs:
  v_mov_b32 v5, 147456
  ds_read_b64 v[8:9], v5
  s_add_u32 m0, s63, 69632
  s_nop 0
  buffer_load_dwordx4 v22, s[32:35], s59 offen lds
  buffer_load_dwordx4 v23, s[32:35], s59 offen offset:1024 lds
  buffer_load_dwordx4 v24, s[32:35], s59 offen offset:2048 lds
  buffer_load_dwordx4 v25, s[32:35], s59 offen offset:3072 lds
  s_add_u32 s59, s59, 32768
  s_add_u32 m0, s49, 131072
  s_nop 0
  buffer_load_dwordx4 v22, s[32:35], s59 offen lds
  buffer_load_dwordx4 v23, s[32:35], s59 offen offset:1024 lds
  buffer_load_dwordx4 v24, s[32:35], s59 offen offset:2048 lds
  buffer_load_dwordx4 v25, s[32:35], s59 offen offset:3072 lds
  s_add_u32 s59, s59, 32768
  s_cmp_eq_u32 s48, 1
  s_cbranch_scc0 L_ld_nbs2
  s_barrier
L_ld_nbs2:
  s_add_u32 m0, s63, 0
  s_nop 0
  buffer_load_dwordx4 v22, s[32:35], s59 offen lds
  buffer_load_dwordx4 v23, s[32:35], s59 offen offset:1024 lds
  buffer_load_dwordx4 v24, s[32:35], s59 offen offset:2048 lds
  buffer_load_dwordx4 v25, s[32:35], s59 offen offset:3072 lds
  s_add_u32 s59, s59, 32768
  s_add_u32 m0, s63, 4096
  s_nop 0
  buffer_load_dwordx4 v22, s[32:35], s59 offen lds
  buffer_load_dwordx4 v23, s[32:35], s59 offen offset:1024 lds
  buffer_load_dwordx4 v24, s[32:35], s59 offen offset:2048 lds
  buffer_load_dwordx4 v25, s[32:35], s59 offen offset:3072 lds
  s_add_u32 s59, s59, 32768
  s_waitcnt lgkmcnt(1)
  s_add_u32 m0, s63, 65536
  s_nop 0
  buffer_load_dwordx4 v22, s[32:35], s13 offen lds
  buffer_load_dwordx4 v23, s[32:35], s13 offen offset:1024 lds
  buffer_load_dwordx4 v24, s[32:35], s13 offen offset:2048 lds
  buffer_load_dwordx4 v25, s[32:35], s13 offen offset:3072 lds
  s_add_u32 s13, s13, 32768
  s_waitcnt vmcnt(16)
  ds_read_b64_tr_b16 v[192:193], v16 offset:4096
  ds_read_b64_tr_b16 v[194:195], v16 offset:5120
  ds_read_b64_tr_b16 v[196:197], v17 offset:4096
  ds_read_b64_tr_b16 v[198:199], v17 offset:5120
  ds_read_b64_tr_b16 v[200:201], v18 offset:4096
  ds_read_b64_tr_b16 v[202:203], v18 offset:5120
  ds_read_b64_tr_b16 v[204:205], v19 offset:4096
  ds_read_b64_tr_b16 v[206:207], v19 offset:5120
  s_lshl_b32 s56, s48, 8
  s_or_b32 s56, s56, s47
  s_cmp_eq_u32 s56, 0
  s_cbranch_scc0 L_ld_nep2
  s_load_dwordx2 s[8:9], s[14:15], 0
L_ld_nep2:
  s_waitcnt lgkmcnt(0)
  s_add_u32 m0, s63, 69632
  s_nop 0
  buffer_load_dwordx4 v22, s[32:35], s13 offen lds
  buffer_load_dwordx4 v23, s[32:35], s13 offen offset:1024 lds
  buffer_load_dwordx4 v24, s[32:35], s13 offen offset:2048 lds
  buffer_load_dwordx4 v25, s[32:35], s13 offen offset:3072 lds
  s_add_u32 s13, s13, 32768
  s_waitcnt vmcnt(16)
  ds_read_b64_tr_b16 v[208:209], v10 offset:0
  ds_read_b64_tr_b16 v[210:211], v10 offset:1024
  ds_read_b64_tr_b16 v[212:213], v11 offset:0
  ds_read_b64_tr_b16 v[214:215], v11 offset:1024
  ds_read_b64_tr_b16 v[216:217], v12 offset:0
  ds_read_b64_tr_b16 v[218:219], v12 offset:1024
  ds_read_b64_tr_b16 v[220:221], v13 offset:0
  ds_read_b64_tr_b16 v[222:223], v13 offset:1024
  s_waitcnt lgkmcnt(0)
  s_add_u32 m0, s49, 131072
  s_nop 0
  buffer_load_dwordx4 v22, s[32:35], s13 offen lds
  buffer_load_dwordx4 v23, s[32:35], s13 offen offset:1024 lds
  buffer_load_dwordx4 v24, s[32:35], s13 offen offset:2048 lds
  buffer_load_dwordx4 v25, s[32:35], s13 offen offset:3072 lds
  s_add_u32 s13, s13, 32768
  s_mov_b64 exec, 0x3fff
  buffer_load_dwordx2 v[34:35], v15, s[36:39], s61 offen sc1
  s_mov_b64 exec, -1
  s_waitcnt vmcnt(17)
  ds_read_b64_tr_b16 v[224:225], v28 offset:0
  ds_read_b64_tr_b16 v[226:227], v28 offset:1024
  ds_read_b64_tr_b16 v[228:229], v29 offset:0
  ds_read_b64_tr_b16 v[230:231], v29 offset:1024
  ds_read_b64_tr_b16 v[232:233], v30 offset:0
  ds_read_b64_tr_b16 v[234:235], v30 offset:1024
  ds_read_b64_tr_b16 v[236:237], v31 offset:0
  ds_read_b64_tr_b16 v[238:239], v31 offset:1024
  s_waitcnt lgkmcnt(0)
  s_add_u32 m0, s63, 0
  s_nop 0
  buffer_load_dwordx4 v22, s[32:35], s13 offen lds
  buffer_load_dwordx4 v23, s[32:35], s13 offen offset:1024 lds
  buffer_load_dwordx4 v24, s[32:35], s13 offen offset:2048 lds
  buffer_load_dwordx4 v25, s[32:35], s13 offen offset:3072 lds
  s_add_u32 s13, s13, 32768
  s_waitcnt vmcnt(17)
  ds_read_b64_tr_b16 v[240:241], v28 offset:4096
  ds_read_b64_tr_b16 v[242:243], v28 offset:5120
  ds_read_b64_tr_b16 v[244:245], v29 offset:4096
  ds_read_b64_tr_b16 v[246:247], v29 offset:5120
  ds_read_b64_tr_b16 v[248:249], v30 offset:4096
  ds_read_b64_tr_b16 v[250:251], v30 offset:5120
  ds_read_b64_tr_b16 v[252:253], v31 offset:4096
  ds_read_b64_tr_b16 v[254:255], v31 offset:5120
  s_mov_b64 exec, 0x3fff
  buffer_load_dwordx2 v[6:7], v15, s[36:39], s61 offen sc1
  s_mov_b64 exec, -1
  s_cmp_eq_u32 s48, 1
  s_cbranch_scc0 L_ld_pathB
  s_waitcnt vmcnt(5)
  s_waitcnt lgkmcnt(0)
  s_mov_b64 exec, 0x3fff
  v_cmp_ne_u64 vcc, v[34:35], v[8:9]
  s_mov_b64 exec, -1
  s_cbranch_vccnz L_ld_failP
  s_add_u32 s56, s60, 0
  buffer_load_dwordx4 v[64:67], v14, s[36:39], s56 offen sc1
  buffer_load_dwordx4 v[68:71], v14, s[36:39], s56 offen offset:2048 sc1
  s_add_u32 s56, s56, 4096
  buffer_load_dwordx4 v[72:75], v14, s[36:39], s56 offen sc1
  buffer_load_dwordx4 v[76:79], v14, s[36:39], s56 offen offset:2048 sc1
  s_add_u32 s56, s56, 4096
  buffer_load_dwordx4 v[80:83], v14, s[36:39], s56 offen sc1
  buffer_load_dwordx4 v[84:87], v14, s[36:39], s56 offen offset:2048 sc1
  s_add_u32 s56, s56, 4096
  buffer_load_dwordx4 v[88:91], v14, s[36:39], s56 offen sc1
  buffer_load_dwordx4 v[92:95], v14, s[36:39], s56 offen offset:2048 sc1
  s_lshl_b32 s56, s47, 2
  s_add_u32 s56, s56, 147472
  v_mov_b32 v5, s56
  v_mov_b32 v6, 1
  ds_write_b32 v5, v6
  s_waitcnt vmcnt(8) lgkmcnt(0)
  s_barrier
  s_add_u32 s56, s60, 114688
  buffer_load_dwordx4 v[96:99], v14, s[36:39], s56 offen sc1
  buffer_load_dwordx4 v[100:103], v14, s[36:39], s56 offen offset:2048 sc1
  s_add_u32 s56, s56, 4096
  buffer_load_dwordx4 v[104:107], v14, s[36:39], s56 offen sc1
  buffer_load_dwordx4 v[108:111], v14, s[36:39], s56 offen offset:2048 sc1
  s_add_u32 s56, s56, 4096
  buffer_load_dwordx4 v[112:115], v14, s[36:39], s56 offen sc1
  buffer_load_dwordx4 v[116:119], v14, s[36:39], s56 offen offset:2048 sc1
  s_add_u32 s56, s56, 4096
  buffer_load_dwordx4 v[120:123], v14, s[36:39], s56 offen sc1
  buffer_load_dwordx4 v[124:127], v14, s[36:39], s56 offen offset:2048 sc1
  s_branch L_ld_mfma
L_ld_failP:
L_ld_pathB:
  s_waitcnt vmcnt(1) lgkmcnt(0)
  s_lshl_b32 s56, s48, 8
  s_or_b32 s56, s56, s47
  s_cmp_eq_u32 s56, 0
  s_cbranch_scc0 L_ld_nf8
  s_waitcnt lgkmcnt(0)
  s_or_b32 s56, s8, s9
  s_cmp_lg_u32 s56, 0
  s_cbranch_scc1 L_ep_ok1
  s_mov_b32 s62, 400000
  v_mov_b32 v5, 0
L_ep_retry1:
  global_load_dwordx2 v[8:9], v5, s[14:15] sc1
  s_sub_u32 s62, s62, 1
  s_cmp_eq_u32 s62, 0
  s_waitcnt vmcnt(0)
  v_readfirstlane_b32 s8, v8
  v_readfirstlane_b32 s9, v9
  s_cbranch_scc1 L_ep_ok1
  s_or_b32 s56, s8, s9
  s_cmp_eq_u32 s56, 0
  s_cbranch_scc1 L_ep_retry1
L_ep_ok1:
  v_mov_b32 v5, 147456
  v_mov_b32 v8, s8
  v_mov_b32 v9, s9
  ds_write_b64 v5, v[8:9]
  s_waitcnt lgkmcnt(0)
L_ld_nf8:
  s_barrier
  v_mov_b32 v5, 147456
  ds_read_b64 v[8:9], v5
  s_mov_b32 s62, 400000
  s_mov_b64 exec, 0x3fff
  s_waitcnt vmcnt(0) lgkmcnt(0)
  v_cmp_ne_u64 vcc, v[6:7], v[8:9]
  s_cbranch_vccz L_polled
L_poll:
  buffer_load_dwordx2 v[6:7], v15, s[36:39], s61 offen sc1
  s_sub_u32 s62, s62, 1
  s_cmp_eq_u32 s62, 0
  s_cbranch_scc1 L_polled
  s_waitcnt vmcnt(0)
  v_cmp_ne_u64 vcc, v[6:7], v[8:9]
  s_cbranch_vccnz L_poll
L_polled:
  s_mov_b64 exec, -1
  s_add_u32 s56, s60, 0
  buffer_load_dwordx4 v[64:67], v14, s[36:39], s56 offen sc1
  buffer_load_dwordx4 v[68:71], v14, s[36:39], s56 offen offset:2048 sc1
  s_add_u32 s56, s56, 4096
  buffer_load_dwordx4 v[72:75], v14, s[36:39], s56 offen sc1
  buffer_load_dwordx4 v[76:79], v14, s[36:39], s56 offen offset:2048 sc1
  s_add_u32 s56, s56, 4096
  buffer_load_dwordx4 v[80:83], v14, s[36:39], s56 offen sc1
  buffer_load_dwordx4 v[84:87], v14, s[36:39], s56 offen offset:2048 sc1
  s_add_u32 s56, s56, 4096
  buffer_load_dwordx4 v[88:91], v14, s[36:39], s56 offen sc1
  buffer_load_dwordx4 v[92:95], v14, s[36:39], s56 offen offset:2048 sc1
  s_add_u32 s56, s60, 114688
  buffer_load_dwordx4 v[96:99], v14, s[36:39], s56 offen sc1
  buffer_load_dwordx4 v[100:103], v14, s[36:39], s56 offen offset:2048 sc1
  s_add_u32 s56, s56, 4096
  buffer_load_dwordx4 v[104:107], v14, s[36:39], s56 offen sc1
  buffer_load_dwordx4 v[108:111], v14, s[36:39], s56 offen offset:2048 sc1
  s_add_u32 s56, s56, 4096
  buffer_load_dwordx4 v[112:115], v14, s[36:39], s56 offen sc1
  buffer_load_dwordx4 v[116:119], v14, s[36:39], s56 offen offset:2048 sc1
  s_add_u32 s56, s56, 4096
  buffer_load_dwordx4 v[120:123], v14, s[36:39], s56 offen sc1
  buffer_load_dwordx4 v[124:127], v14, s[36:39], s56 offen offset:2048 sc1
  s_lshl_b32 s56, s47, 2
  s_add_u32 s56, s56, 147472
  v_mov_b32 v5, s56
  v_mov_b32 v6, 1
  ds_write_b32 v5, v6
L_ld_mfma:
  v_and_b32 v5, 15, v2
  v_lshrrev_b32 v6, 4, v2
  v_xor_b32 v6, v6, v5
  v_lshlrev_b32 v5, 8, v5
  s_lshl_b32 s56, s47, 13
  s_add_u32 s56, s56, 98304
  v_add_u32 v5, s56, v5
  v_xor_b32 v7, 0, v6
  v_lshl_add_u32 v10, v7, 4, v5
  v_xor_b32 v7, 4, v6
  v_lshl_add_u32 v11, v7, 4, v5
  v_xor_b32 v7, 8, v6
  v_lshl_add_u32 v12, v7, 4, v5
  v_xor_b32 v7, 12, v6
  v_lshl_add_u32 v13, v7, 4, v5
  s_waitcnt vmcnt(15)
  v_mfma_f32_16x16x32_bf16 v[32:35], v[128:131], v[64:67], 0
  v_mfma_f32_16x16x32_bf16 v[36:39], v[132:135], v[64:67], 0
  v_mfma_f32_16x16x32_bf16 v[40:43], v[136:139], v[64:67], 0
  v_mfma_f32_16x16x32_bf16 v[44:47], v[140:143], v[64:67], 0
  s_waitcnt vmcnt(14)
  v_mfma_f32_16x16x32_bf16 v[32:35], v[144:147], v[68:71], v[32:35]
  v_mfma_f32_16x16x32_bf16 v[36:39], v[148:151], v[68:71], v[36:39]
  v_mfma_f32_16x16x32_bf16 v[40:43], v[152:155], v[68:71], v[40:43]
  v_mfma_f32_16x16x32_bf16 v[44:47], v[156:159], v[68:71], v[44:47]
  s_waitcnt vmcnt(13)
  v_mfma_f32_16x16x32_bf16 v[32:35], v[160:163], v[72:75], v[32:35]
  v_mfma_f32_16x16x32_bf16 v[36:39], v[164:167], v[72:75], v[36:39]
  v_mfma_f32_16x16x32_bf16 v[40:43], v[168:171], v[72:75], v[40:43]
  v_mfma_f32_16x16x32_bf16 v[44:47], v[172:175], v[72:75], v[44:47]
  s_waitcnt vmcnt(12)
  v_mfma_f32_16x16x32_bf16 v[32:35], v[176:179], v[76:79], v[32:35]
  v_mfma_f32_16x16x32_bf16 v[36:39], v[180:183], v[76:79], v[36:39]
  v_mfma_f32_16x16x32_bf16 v[40:43], v[184:187], v[76:79], v[40:43]
  v_mfma_f32_16x16x32_bf16 v[44:47], v[188:191], v[76:79], v[44:47]
  s_waitcnt vmcnt(11)
  v_mfma_f32_16x16x32_bf16 v[32:35], v[192:195], v[80:83], v[32:35]
  v_mfma_f32_16x16x32_bf16 v[36:39], v[196:199], v[80:83], v[36:39]
  v_mfma_f32_16x16x32_bf16 v[40:43], v[200:203], v[80:83], v[40:43]
  v_mfma_f32_16x16x32_bf16 v[44:47], v[204:207], v[80:83], v[44:47]
  s_waitcnt vmcnt(10)
  v_mfma_f32_16x16x32_bf16 v[32:35], v[208:211], v[84:87], v[32:35]
  v_mfma_f32_16x16x32_bf16 v[36:39], v[212:215], v[84:87], v[36:39]
  v_mfma_f32_16x16x32_bf16 v[40:43], v[216:219], v[84:87], v[40:43]
  v_mfma_f32_16x16x32_bf16 v[44:47], v[220:223], v[84:87], v[44:47]
  s_waitcnt vmcnt(9)
  v_mfma_f32_16x16x32_bf16 v[32:35], v[224:227], v[88:91], v[32:35]
  v_mfma_f32_16x16x32_bf16 v[36:39], v[228:231], v[88:91], v[36:39]
  v_mfma_f32_16x16x32_bf16 v[40:43], v[232:235], v[88:91], v[40:43]
  v_mfma_f32_16x16x32_bf16 v[44:47], v[236:239], v[88:91], v[44:47]
  s_waitcnt vmcnt(8)
  v_mfma_f32_16x16x32_bf16 v[32:35], v[240:243], v[92:95], v[32:35]
  v_mfma_f32_16x16x32_bf16 v[36:39], v[244:247], v[92:95], v[36:39]
  v_mfma_f32_16x16x32_bf16 v[40:43], v[248:251], v[92:95], v[40:43]
  v_mfma_f32_16x16x32_bf16 v[44:47], v[252:255], v[92:95], v[44:47]
  s_waitcnt vmcnt(7)
  v_mfma_f32_16x16x32_bf16 v[48:51], v[128:131], v[96:99], 0
  v_mfma_f32_16x16x32_bf16 v[52:55], v[132:135], v[96:99], 0
  v_mfma_f32_16x16x32_bf16 v[56:59], v[136:139], v[96:99], 0
  v_mfma_f32_16x16x32_bf16 v[60:63], v[140:143], v[96:99], 0
  s_waitcnt vmcnt(6)
  v_mfma_f32_16x16x32_bf16 v[48:51], v[144:147], v[100:103], v[48:51]
  v_mfma_f32_16x16x32_bf16 v[52:55], v[148:151], v[100:103], v[52:55]
  v_mfma_f32_16x16x32_bf16 v[56:59], v[152:155], v[100:103], v[56:59]
  v_mfma_f32_16x16x32_bf16 v[60:63], v[156:159], v[100:103], v[60:63]
  ds_write_b128 v10, v[32:35]
  ds_write_b128 v11, v[36:39]
  ds_write_b128 v12, v[40:43]
  ds_write_b128 v13, v[44:47]
  s_waitcnt vmcnt(5)
  v_mfma_f32_16x16x32_bf16 v[48:51], v[160:163], v[104:107], v[48:51]
  v_mfma_f32_16x16x32_bf16 v[52:55], v[164:167], v[104:107], v[52:55]
  v_mfma_f32_16x16x32_bf16 v[56:59], v[168:171], v[104:107], v[56:59]
  v_mfma_f32_16x16x32_bf16 v[60:63], v[172:175], v[104:107], v[60:63]
  s_waitcnt vmcnt(4)
  v_mfma_f32_16x16x32_bf16 v[48:51], v[176:179], v[108:111], v[48:51]
  v_mfma_f32_16x16x32_bf16 v[52:55], v[180:183], v[108:111], v[52:55]
  v_mfma_f32_16x16x32_bf16 v[56:59], v[184:187], v[108:111], v[56:59]
  v_mfma_f32_16x16x32_bf16 v[60:63], v[188:191], v[108:111], v[60:63]
  s_waitcnt vmcnt(3)
  v_mfma_f32_16x16x32_bf16 v[48:51], v[192:195], v[112:115], v[48:51]
  v_mfma_f32_16x16x32_bf16 v[52:55], v[196:199], v[112:115], v[52:55]
  v_mfma_f32_16x16x32_bf16 v[56:59], v[200:203], v[112:115], v[56:59]
  v_mfma_f32_16x16x32_bf16 v[60:63], v[204:207], v[112:115], v[60:63]
  s_waitcnt vmcnt(2)
  v_mfma_f32_16x16x32_bf16 v[48:51], v[208:211], v[116:119], v[48:51]
  v_mfma_f32_16x16x32_bf16 v[52:55], v[212:215], v[116:119], v[52:55]
  v_mfma_f32_16x16x32_bf16 v[56:59], v[216:219], v[116:119], v[56:59]
  v_mfma_f32_16x16x32_bf16 v[60:63], v[220:223], v[116:119], v[60:63]
  s_waitcnt vmcnt(1)
  v_mfma_f32_16x16x32_bf16 v[48:51], v[224:227], v[120:123], v[48:51]
  v_mfma_f32_16x16x32_bf16 v[52:55], v[228:231], v[120:123], v[52:55]
  v_mfma_f32_16x16x32_bf16 v[56:59], v[232:235], v[120:123], v[56:59]
  v_mfma_f32_16x16x32_bf16 v[60:63], v[236:239], v[120:123], v[60:63]
  s_waitcnt vmcnt(0)
  v_mfma_f32_16x16x32_bf16 v[48:51], v[240:243], v[124:127], v[48:51]
  v_mfma_f32_16x16x32_bf16 v[52:55], v[244:247], v[124:127], v[52:55]
  v_mfma_f32_16x16x32_bf16 v[56:59], v[248:251], v[124:127], v[56:59]
  v_mfma_f32_16x16x32_bf16 v[60:63], v[252:255], v[124:127], v[60:63]
  s_nop 7
  s_nop 1
  ds_write_b128 v10, v[48:51] offset:4096
  ds_write_b128 v11, v[52:55] offset:4096
  ds_write_b128 v12, v[56:59] offset:4096
  ds_write_b128 v13, v[60:63] offset:4096
  s_waitcnt lgkmcnt(0)
  s_branch L_final
L_compute:
  v_mov_b32 v18, 0
  v_bfe_u32 v5, v2, 2, 2
  v_bfe_u32 v6, v2, 4, 1
  v_lshrrev_b32 v7, 5, v2
  v_and_b32 v8, 3, v2
  v_lshlrev_b32 v9, 5, v6
  v_lshl_add_u32 v9, v8, 3, v9
  v_lshl_add_u32 v9, v5, 7, v9
  v_lshrrev_b32 v10, 1, v5
  s_lshr_b32 s56, s44, 1
  v_xor_b32 v13, s56, v10
  v_lshl_add_u32 v13, v13, 6, v9
  v_lshl_add_u32 v13, v7, 10, v13
  v_and_b32 v14, 31, v2
  v_bfe_u32 v15, v2, 1, 3
  v_xor_b32 v15, v15, v7
  v_lshlrev_b32 v14, 7, v14
  v_lshl_add_u32 v14, v15, 4, v14
  s_and_b32 s56, s44, 1
  s_lshl_b32 s56, s56, 13
  v_add_u32 v14, s56, v14
  v_xor_b32 v15, 32, v14
  v_xor_b32 v16, 64, v14
  v_xor_b32 v17, 96, v14
  v_lshlrev_b32 v12, 4, v2
  v_mov_b32 v11, 147456
  v_mov_b32 v19, 0
  s_mov_b32 s64, 1.0
  s_mov_b32 s65, 1.0
  s_mov_b32 s66, 0xbfb8aa3b
  s_mov_b32 s67, 0xbfb8aa3b
  v_lshrrev_b32 v5, 4, v2
  v_bfe_u32 v6, v2, 2, 2
  v_and_b32 v7, 3, v2
  v_lshrrev_b32 v8, 1, v5
  v_lshlrev_b32 v8, 4, v8
  v_and_b32 v9, 1, v5
  v_lshl_add_u32 v8, v9, 2, v8
  v_add_u32 v8, v8, v6
  v_lshlrev_b32 v8, 7, v8
  v_lshrrev_b32 v5, 1, v7
  v_lshrrev_b32 v6, 1, v6
  v_lshl_add_u32 v5, v6, 2, v5
  v_lshlrev_b32 v9, 1, v9
  v_xor_b32 v5, v5, v9
  v_lshl_add_u32 v8, v5, 4, v8
  v_and_b32 v7, 1, v7
  v_lshl_add_u32 v248, v7, 3, v8
  v_xor_b32 v249, 32, v248
  v_xor_b32 v250, 64, v248
  v_xor_b32 v251, 96, v248
  s_lshl_b32 s63, s47, 13
  v_add_u32 v248, s63, v248
  v_add_u32 v249, s63, v249
  v_add_u32 v250, s63, v250
  v_add_u32 v251, s63, v251
  v_lshrrev_b32 v5, 5, v2
  v_bfe_u32 v6, v2, 4, 1
  v_and_b32 v7, 15, v2
  v_lshlrev_b32 v5, 10, v5
  v_lshl_add_u32 v5, v6, 9, v5
  v_lshl_add_u32 v5, v7, 4, v5
  s_and_b32 s56, s3, 1
  s_lshl_b32 s56, s56, 8
  v_add_u32 v252, s56, v5
  s_mul_i32 s56, s47, 14
  s_add_u32 s56, s56, 8
  s_lshr_b32 s57, s3, 1
  s_mul_i32 s57, s57, 112
  s_add_u32 s57, s57, s56
  s_lshl_b32 s60, s57, 11
  s_and_b32 s56, s44, 1
  s_lshl_b32 s57, s45, 1
  s_add_u32 s56, s56, s57
  s_mul_i32 s57, s56, 56
  s_lshr_b32 s61, s44, 1
  s_lshl_b32 s58, s46, 1
  s_add_u32 s61, s61, s58
  s_add_u32 s58, s57, s61
  s_lshl_b32 s58, s58, 7
  s_lshl_b32 s57, s57, 1
  s_add_u32 s57, s57, s61
  s_lshl_b32 s13, s57, 11
  s_add_u32 s61, s58, 4194304
  v_mov_b32 v52, 0
  v_mov_b32 v53, 0
  v_mov_b32 v54, 0
  v_mov_b32 v55, 0
  v_mov_b32 v56, 0
  v_mov_b32 v57, 0
  v_mov_b32 v58, 0
  v_mov_b32 v59, 0
  v_mov_b32 v60, 0
  v_mov_b32 v61, 0
  v_mov_b32 v62, 0
  v_mov_b32 v63, 0
  v_mov_b32 v64, 0
  v_mov_b32 v65, 0
  v_mov_b32 v66, 0
  v_mov_b32 v67, 0
  v_mov_b32 v68, 0
  v_mov_b32 v69, 0
  v_mov_b32 v70, 0
  v_mov_b32 v71, 0
  v_mov_b32 v72, 0
  v_mov_b32 v73, 0
  v_mov_b32 v74, 0
  v_mov_b32 v75, 0
  v_mov_b32 v76, 0
  v_mov_b32 v77, 0
  v_mov_b32 v78, 0
  v_mov_b32 v79, 0
  v_mov_b32 v80, 0
  v_mov_b32 v81, 0
  v_mov_b32 v82, 0
  v_mov_b32 v83, 0
  v_mov_b32 v84, 0
  v_mov_b32 v85, 0
  v_mov_b32 v86, 0
  v_mov_b32 v87, 0
  v_mov_b32 v88, 0
  v_mov_b32 v89, 0
  v_mov_b32 v90, 0
  v_mov_b32 v91, 0
  v_mov_b32 v92, 0
  v_mov_b32 v93, 0
  v_mov_b32 v94, 0
  v_mov_b32 v95, 0
  v_mov_b32 v96, 0
  v_mov_b32 v97, 0
  v_mov_b32 v98, 0
  v_mov_b32 v99, 0
  v_mov_b32 v100, 0
  v_mov_b32 v101, 0
  v_mov_b32 v102, 0
  v_mov_b32 v103, 0
  v_mov_b32 v104, 0
  v_mov_b32 v105, 0
  v_mov_b32 v106, 0
  v_mov_b32 v107, 0
  v_mov_b32 v108, 0
  v_mov_b32 v109, 0
  v_mov_b32 v110, 0
  v_mov_b32 v111, 0
  v_mov_b32 v112, 0
  v_mov_b32 v113, 0
  v_mov_b32 v114, 0
  v_mov_b32 v115, 0
  s_cmp_eq_u32 s44, 3
  s_waitcnt lgkmcnt(0)
  s_cbranch_scc0 L_c_nw3
  v_mov_b32 v20, 0
  v_mov_b32 v21, 0
  v_mov_b32 v22, 0
  v_mov_b32 v23, 0
  ds_write_b128 v11, v[20:23] offset:16
  s_waitcnt lgkmcnt(0)
L_c_nw3:
  s_cmp_eq_u32 s48, 1
  s_cbranch_scc0 L_c_b8
  s_barrier
  ds_read_b64_tr_b16 v[20:21], v13 offset:16384
  ds_read_b64_tr_b16 v[22:23], v13 offset:16896
  ds_read_b128 v[28:31], v14
  ds_read_b64_tr_b16 v[24:25], v13 offset:18432
  ds_read_b64_tr_b16 v[26:27], v13 offset:18944
  ds_read_b128 v[32:35], v14 offset:4096
  ds_read_b64_tr_b16 v[36:37], v13 offset:20480
  ds_read_b64_tr_b16 v[38:39], v13 offset:20992
  ds_read_b128 v[44:47], v15
  ds_read_b64_tr_b16 v[40:41], v13 offset:22528
  ds_read_b64_tr_b16 v[42:43], v13 offset:23040
  ds_read_b128 v[48:51], v15 offset:4096
  s_mov_b32 s58, 7
  s_mov_b32 s55, 0
L_k_loop:
  s_waitcnt lgkmcnt(6)
  v_mfma_f32_32x32x16_bf16 v[52:67], v[20:23], v[28:31], v[52:67]
  ds_read_b64_tr_b16 v[116:117], v13 offset:24576
  ds_read_b64_tr_b16 v[118:119], v13 offset:25088
  ds_read_b128 v[124:127], v16
  v_mfma_f32_32x32x16_bf16 v[68:83], v[24:27], v[28:31], v[68:83]
  ds_read_b64_tr_b16 v[120:121], v13 offset:26624
  ds_read_b64_tr_b16 v[122:123], v13 offset:27136
  ds_read_b128 v[128:131], v16 offset:4096
  v_mfma_f32_32x32x16_bf16 v[84:99], v[20:23], v[32:35], v[84:99]
  v_mfma_f32_32x32x16_bf16 v[100:115], v[24:27], v[32:35], v[100:115]
  s_waitcnt lgkmcnt(6)
  v_mfma_f32_32x32x16_bf16 v[52:67], v[36:39], v[44:47], v[52:67]
  ds_read_b64_tr_b16 v[132:133], v13 offset:28672
  ds_read_b64_tr_b16 v[134:135], v13 offset:29184
  ds_read_b128 v[140:143], v17
  v_mfma_f32_32x32x16_bf16 v[68:83], v[40:43], v[44:47], v[68:83]
  ds_read_b64_tr_b16 v[136:137], v13 offset:30720
  ds_read_b64_tr_b16 v[138:139], v13 offset:31232
  ds_read_b128 v[144:147], v17 offset:4096
  v_mfma_f32_32x32x16_bf16 v[84:99], v[36:39], v[48:51], v[84:99]
  v_mfma_f32_32x32x16_bf16 v[100:115], v[40:43], v[48:51], v[100:115]
  s_waitcnt lgkmcnt(0)
  v_mfma_f32_32x32x16_bf16 v[52:67], v[116:119], v[124:127], v[52:67]
  s_add_u32 s56, s55, 32768
  s_and_b32 s56, s56, 0x1ffff
  s_sub_u32 s57, s56, s55
  s_mov_b32 s55, s56
  v_add_u32 v13, s57, v13
  v_add_u32 v14, s57, v14
  v_add_u32 v15, s57, v15
  v_add_u32 v16, s57, v16
  v_add_u32 v17, s57, v17
  v_mfma_f32_32x32x16_bf16 v[68:83], v[120:123], v[124:127], v[68:83]
  s_barrier
  ds_read_b64_tr_b16 v[20:21], v13 offset:16384
  ds_read_b64_tr_b16 v[22:23], v13 offset:16896
  ds_read_b128 v[28:31], v14
  v_mfma_f32_32x32x16_bf16 v[84:99], v[116:119], v[128:131], v[84:99]
  ds_read_b64_tr_b16 v[24:25], v13 offset:18432
  ds_read_b64_tr_b16 v[26:27], v13 offset:18944
  ds_read_b128 v[32:35], v14 offset:4096
  v_mfma_f32_32x32x16_bf16 v[100:115], v[120:123], v[128:131], v[100:115]
  v_mfma_f32_32x32x16_bf16 v[52:67], v[132:135], v[140:143], v[52:67]
  ds_read_b64_tr_b16 v[36:37], v13 offset:20480
  ds_read_b64_tr_b16 v[38:39], v13 offset:20992
  ds_read_b128 v[44:47], v15
  v_mfma_f32_32x32x16_bf16 v[68:83], v[136:139], v[140:143], v[68:83]
  ds_read_b64_tr_b16 v[40:41], v13 offset:22528
  ds_read_b64_tr_b16 v[42:43], v13 offset:23040
  ds_read_b128 v[48:51], v15 offset:4096
  v_mfma_f32_32x32x16_bf16 v[84:99], v[132:135], v[144:147], v[84:99]
  v_mfma_f32_32x32x16_bf16 v[100:115], v[136:139], v[144:147], v[100:115]
  s_sub_u32 s58, s58, 1
  s_cmp_lg_u32 s58, 0
  s_cbranch_scc1 L_k_loop
  s_waitcnt lgkmcnt(9)
  v_mfma_f32_32x32x16_bf16 v[52:67], v[20:23], v[28:31], v[52:67]
  ds_read_b64_tr_b16 v[116:117], v13 offset:24576
  ds_read_b64_tr_b16 v[118:119], v13 offset:25088
  ds_read_b128 v[124:127], v16
  s_waitcnt lgkmcnt(10)
  v_mfma_f32_32x32x16_bf16 v[68:83], v[24:27], v[28:31], v[68:83]
  ds_read_b64_tr_b16 v[120:121], v13 offset:26624
  ds_read_b64_tr_b16 v[122:123], v13 offset:27136
  ds_read_b64_tr_b16 v[132:133], v13 offset:28672
  s_waitcnt lgkmcnt(9)
  v_mfma_f32_32x32x16_bf16 v[52:67], v[36:39], v[44:47], v[52:67]
  ds_read_b64_tr_b16 v[134:135], v13 offset:29184
  ds_read_b128 v[140:143], v17
  ds_read_b64_tr_b16 v[136:137], v13 offset:30720
  ds_read_b64 v[254:255], v11
  s_waitcnt lgkmcnt(11)
  v_mfma_f32_32x32x16_bf16 v[68:83], v[40:43], v[44:47], v[68:83]
  ds_read_b64_tr_b16 v[138:139], v13 offset:31232
  ds_read_b128 v[128:131], v16 offset:4096
  ds_read_b128 v[144:147], v17 offset:4096
  s_waitcnt lgkmcnt(10)
  v_mfma_f32_32x32x16_bf16 v[52:67], v[116:119], v[124:127], v[52:67]
  s_waitcnt lgkmcnt(8)
  v_mfma_f32_32x32x16_bf16 v[68:83], v[120:123], v[124:127], v[68:83]
  s_waitcnt lgkmcnt(5)
  v_mfma_f32_32x32x16_bf16 v[52:67], v[132:135], v[140:143], v[52:67]
  s_waitcnt lgkmcnt(2)
  v_mfma_f32_32x32x16_bf16 v[68:83], v[136:139], v[140:143], v[68:83]
  s_add_u32 s57, s13, 114688
  v_mfma_f32_32x32x16_bf16 v[84:99], v[20:23], v[32:35], v[84:99]
  v_mfma_f32_32x32x16_bf16 v[100:115], v[24:27], v[32:35], v[100:115]
  v_mul_f32 v232, s66, v52
  v_mul_f32 v233, s66, v53
  v_mul_f32 v234, s66, v54
  v_mul_f32 v235, s66, v55
  v_exp_f32 v232, v232
  v_mfma_f32_32x32x16_bf16 v[84:99], v[36:39], v[48:51], v[84:99]
  v_exp_f32 v233, v233
  v_exp_f32 v234, v234
  v_exp_f32 v235, v235
  v_mfma_f32_32x32x16_bf16 v[100:115], v[40:43], v[48:51], v[100:115]
  v_mul_f32 v68, v52, v68
  v_mul_f32 v69, v53, v69
  v_mul_f32 v70, v54, v70
  v_mul_f32 v71, v55, v71
  v_add_f32 v232, 1.0, v232
  v_add_f32 v233, 1.0, v233
  s_waitcnt lgkmcnt(1)
  v_mfma_f32_32x32x16_bf16 v[84:99], v[116:119], v[128:131], v[84:99]
  v_add_f32 v234, 1.0, v234
  v_add_f32 v235, 1.0, v235
  v_rcp_f32 v232, v232
  v_rcp_f32 v233, v233
  v_mfma_f32_32x32x16_bf16 v[100:115], v[120:123], v[128:131], v[100:115]
  v_rcp_f32 v234, v234
  v_rcp_f32 v235, v235
  v_mul_f32 v68, v68, v232
  v_mul_f32 v69, v69, v233
  s_waitcnt lgkmcnt(0)
  v_mfma_f32_32x32x16_bf16 v[84:99], v[132:135], v[144:147], v[84:99]
  v_mul_f32 v70, v70, v234
  v_mul_f32 v71, v71, v235
  v_cvt_pk_bf16_f32 v52, v68, v69
  v_cvt_pk_bf16_f32 v53, v70, v71
  v_mul_f32 v236, s66, v56
  v_mul_f32 v237, s66, v57
  v_mfma_f32_32x32x16_bf16 v[100:115], v[136:139], v[144:147], v[100:115]
  v_mul_f32 v238, s66, v58
  v_mul_f32 v239, s66, v59
  v_exp_f32 v236, v236
  v_exp_f32 v237, v237
  v_exp_f32 v238, v238
  v_exp_f32 v239, v239
  v_mul_f32 v72, v56, v72
  v_mul_f32 v73, v57, v73
  v_mul_f32 v74, v58, v74
  v_mul_f32 v75, v59, v75
  v_add_f32 v236, 1.0, v236
  v_add_f32 v237, 1.0, v237
  v_add_f32 v238, 1.0, v238
  v_add_f32 v239, 1.0, v239
  v_rcp_f32 v236, v236
  v_rcp_f32 v237, v237
  v_rcp_f32 v238, v238
  v_rcp_f32 v239, v239
  v_mul_f32 v72, v72, v236
  v_mul_f32 v73, v73, v237
  v_mul_f32 v74, v74, v238
  v_mul_f32 v75, v75, v239
  v_cvt_pk_bf16_f32 v54, v72, v73
  v_cvt_pk_bf16_f32 v55, v74, v75
  buffer_store_dwordx4 v[52:55], v12, s[36:39], s13 offen sc1
  v_mul_f32 v232, s66, v60
  v_mul_f32 v233, s66, v61
  v_mul_f32 v234, s66, v62
  v_mul_f32 v235, s66, v63
  v_exp_f32 v232, v232
  v_exp_f32 v233, v233
  v_exp_f32 v234, v234
  v_exp_f32 v235, v235
  v_mul_f32 v76, v60, v76
  v_mul_f32 v77, v61, v77
  v_mul_f32 v78, v62, v78
  v_mul_f32 v79, v63, v79
  v_add_f32 v232, 1.0, v232
  v_add_f32 v233, 1.0, v233
  v_add_f32 v234, 1.0, v234
  v_add_f32 v235, 1.0, v235
  v_rcp_f32 v232, v232
  v_rcp_f32 v233, v233
  v_rcp_f32 v234, v234
  v_rcp_f32 v235, v235
  v_mul_f32 v76, v76, v232
  v_mul_f32 v77, v77, v233
  v_mul_f32 v78, v78, v234
  v_mul_f32 v79, v79, v235
  v_cvt_pk_bf16_f32 v56, v76, v77
  v_cvt_pk_bf16_f32 v57, v78, v79
  v_mul_f32 v236, s66, v64
  v_mul_f32 v237, s66, v65
  v_mul_f32 v238, s66, v66
  v_mul_f32 v239, s66, v67
  v_exp_f32 v236, v236
  v_exp_f32 v237, v237
  v_exp_f32 v238, v238
  v_exp_f32 v239, v239
  v_mul_f32 v80, v64, v80
  v_mul_f32 v81, v65, v81
  v_mul_f32 v82, v66, v82
  v_mul_f32 v83, v67, v83
  v_add_f32 v236, 1.0, v236
  v_add_f32 v237, 1.0, v237
  v_add_f32 v238, 1.0, v238
  v_add_f32 v239, 1.0, v239
  v_rcp_f32 v236, v236
  v_rcp_f32 v237, v237
  v_rcp_f32 v238, v238
  v_rcp_f32 v239, v239
  v_mul_f32 v80, v80, v236
  v_mul_f32 v81, v81, v237
  v_mul_f32 v82, v82, v238
  v_mul_f32 v83, v83, v239
  v_cvt_pk_bf16_f32 v58, v80, v81
  v_cvt_pk_bf16_f32 v59, v82, v83
  buffer_store_dwordx4 v[56:59], v12, s[36:39], s13 offen offset:1024 sc1
  v_pk_mul_f32 v[232:233], v[84:85], s[66:67]
  v_pk_mul_f32 v[234:235], v[86:87], s[66:67]
  v_exp_f32 v232, v232
  v_exp_f32 v233, v233
  v_exp_f32 v234, v234
  v_exp_f32 v235, v235
  v_pk_mul_f32 v[100:101], v[84:85], v[100:101]
  v_pk_mul_f32 v[102:103], v[86:87], v[102:103]
  v_pk_add_f32 v[232:233], v[232:233], s[64:65]
  v_pk_add_f32 v[234:235], v[234:235], s[64:65]
  v_rcp_f32 v232, v232
  v_rcp_f32 v233, v233
  v_rcp_f32 v234, v234
  v_rcp_f32 v235, v235
  s_nop 0
  v_pk_mul_f32 v[100:101], v[100:101], v[232:233]
  v_pk_mul_f32 v[102:103], v[102:103], v[234:235]
  v_cvt_pk_bf16_f32 v84, v100, v101
  v_cvt_pk_bf16_f32 v85, v102, v103
  v_pk_mul_f32 v[236:237], v[88:89], s[66:67]
  v_pk_mul_f32 v[238:239], v[90:91], s[66:67]
  v_exp_f32 v236, v236
  v_exp_f32 v237, v237
  v_exp_f32 v238, v238
  v_exp_f32 v239, v239
  v_pk_mul_f32 v[104:105], v[88:89], v[104:105]
  v_pk_mul_f32 v[106:107], v[90:91], v[106:107]
  v_pk_add_f32 v[236:237], v[236:237], s[64:65]
  v_pk_add_f32 v[238:239], v[238:239], s[64:65]
  v_rcp_f32 v236, v236
  v_rcp_f32 v237, v237
  v_rcp_f32 v238, v238
  v_rcp_f32 v239, v239
  s_nop 0
  v_pk_mul_f32 v[104:105], v[104:105], v[236:237]
  v_pk_mul_f32 v[106:107], v[106:107], v[238:239]
  v_cvt_pk_bf16_f32 v86, v104, v105
  v_cvt_pk_bf16_f32 v87, v106, v107
  buffer_store_dwordx4 v[84:87], v12, s[36:39], s57 offen sc1
  v_pk_mul_f32 v[232:233], v[92:93], s[66:67]
  v_pk_mul_f32 v[234:235], v[94:95], s[66:67]
  v_exp_f32 v232, v232
  v_exp_f32 v233, v233
  v_exp_f32 v234, v234
  v_exp_f32 v235, v235
  v_pk_mul_f32 v[108:109], v[92:93], v[108:109]
  v_pk_mul_f32 v[110:111], v[94:95], v[110:111]
  v_pk_add_f32 v[232:233], v[232:233], s[64:65]
  v_pk_add_f32 v[234:235], v[234:235], s[64:65]
  v_rcp_f32 v232, v232
  v_rcp_f32 v233, v233
  v_rcp_f32 v234, v234
  v_rcp_f32 v235, v235
  s_nop 0
  v_pk_mul_f32 v[108:109], v[108:109], v[232:233]
  v_pk_mul_f32 v[110:111], v[110:111], v[234:235]
  v_cvt_pk_bf16_f32 v88, v108, v109
  v_cvt_pk_bf16_f32 v89, v110, v111
  v_pk_mul_f32 v[236:237], v[96:97], s[66:67]
  v_pk_mul_f32 v[238:239], v[98:99], s[66:67]
  v_exp_f32 v236, v236
  v_exp_f32 v237, v237
  v_exp_f32 v238, v238
  v_exp_f32 v239, v239
  v_pk_mul_f32 v[112:113], v[96:97], v[112:113]
  v_pk_mul_f32 v[114:115], v[98:99], v[114:115]
  v_pk_add_f32 v[236:237], v[236:237], s[64:65]
  v_pk_add_f32 v[238:239], v[238:239], s[64:65]
  v_rcp_f32 v236, v236
  v_rcp_f32 v237, v237
  v_rcp_f32 v238, v238
  v_rcp_f32 v239, v239
  s_nop 0
  v_pk_mul_f32 v[112:113], v[112:113], v[236:237]
  v_pk_mul_f32 v[114:115], v[114:115], v[238:239]
  v_cvt_pk_bf16_f32 v90, v112, v113
  v_cvt_pk_bf16_f32 v91, v114, v115
  buffer_store_dwordx4 v[88:91], v12, s[36:39], s57 offen offset:1024 sc1
  s_barrier
  s_waitcnt vmcnt(0)
  s_mov_b64 exec, 1
  buffer_store_dwordx2 v[254:255], v18, s[36:39], s61 offen sc1
  s_mov_b64 exec, -1
  s_barrier
L_c_b8:
  s_waitcnt lgkmcnt(0)
  s_barrier
  v_add_u32 v14, 65536, v248
  v_add_u32 v15, 65536, v249
  v_add_u32 v16, 65536, v250
  v_add_u32 v17, 65536, v251
  s_lshl_b32 s56, s47, 12
  s_sub_u32 s56, 131072, s56
  v_add_u32 v20, s56, v248
  v_add_u32 v21, s56, v249
  v_add_u32 v22, s56, v250
  v_add_u32 v23, s56, v251
  ds_read_b64_tr_b16 v[148:149], v248 offset:32768
  ds_read_b64_tr_b16 v[150:151], v248 offset:33792
  ds_read_b64_tr_b16 v[152:153], v249 offset:32768
  ds_read_b64_tr_b16 v[154:155], v249 offset:33792
  ds_read_b64_tr_b16 v[156:157], v250 offset:32768
  ds_read_b64_tr_b16 v[158:159], v250 offset:33792
  ds_read_b64_tr_b16 v[160:161], v251 offset:32768
  ds_read_b64_tr_b16 v[162:163], v251 offset:33792
  s_waitcnt lgkmcnt(0)
  ds_read_b64_tr_b16 v[164:165], v248 offset:36864
  ds_read_b64_tr_b16 v[166:167], v248 offset:37888
  ds_read_b64_tr_b16 v[168:169], v249 offset:36864
  ds_read_b64_tr_b16 v[170:171], v249 offset:37888
  ds_read_b64_tr_b16 v[172:173], v250 offset:36864
  ds_read_b64_tr_b16 v[174:175], v250 offset:37888
  ds_read_b64_tr_b16 v[176:177], v251 offset:36864
  ds_read_b64_tr_b16 v[178:179], v251 offset:37888
  s_waitcnt lgkmcnt(0)
  ds_read_b64_tr_b16 v[180:181], v14 offset:0
  ds_read_b64_tr_b16 v[182:183], v14 offset:1024
  ds_read_b64_tr_b16 v[184:185], v15 offset:0
  ds_read_b64_tr_b16 v[186:187], v15 offset:1024
  ds_read_b64_tr_b16 v[188:189], v16 offset:0
  ds_read_b64_tr_b16 v[190:191], v16 offset:1024
  ds_read_b64_tr_b16 v[192:193], v17 offset:0
  ds_read_b64_tr_b16 v[194:195], v17 offset:1024
  s_waitcnt lgkmcnt(0)
  ds_read_b64_tr_b16 v[196:197], v14 offset:4096
  ds_read_b64_tr_b16 v[198:199], v14 offset:5120
  ds_read_b64_tr_b16 v[200:201], v15 offset:4096
  ds_read_b64_tr_b16 v[202:203], v15 offset:5120
  ds_read_b64_tr_b16 v[204:205], v16 offset:4096
  ds_read_b64_tr_b16 v[206:207], v16 offset:5120
  ds_read_b64_tr_b16 v[208:209], v17 offset:4096
  ds_read_b64_tr_b16 v[210:211], v17 offset:5120
  s_waitcnt lgkmcnt(0)
  ds_read_b64_tr_b16 v[212:213], v20 offset:0
  ds_read_b64_tr_b16 v[214:215], v20 offset:1024
  ds_read_b64_tr_b16 v[216:217], v21 offset:0
  ds_read_b64_tr_b16 v[218:219], v21 offset:1024
  ds_read_b64_tr_b16 v[220:221], v22 offset:0
  ds_read_b64_tr_b16 v[222:223], v22 offset:1024
  ds_read_b64_tr_b16 v[224:225], v23 offset:0
  ds_read_b64_tr_b16 v[226:227], v23 offset:1024
  s_waitcnt lgkmcnt(0)
  ds_read_b64_tr_b16 v[228:229], v248 offset:0
  ds_read_b64_tr_b16 v[230:231], v248 offset:1024
  ds_read_b64_tr_b16 v[232:233], v249 offset:0
  ds_read_b64_tr_b16 v[234:235], v249 offset:1024
  ds_read_b64_tr_b16 v[236:237], v250 offset:0
  ds_read_b64_tr_b16 v[238:239], v250 offset:1024
  ds_read_b64_tr_b16 v[240:241], v251 offset:0
  ds_read_b64_tr_b16 v[242:243], v251 offset:1024
  s_lshl_b32 s56, s47, 2
  s_add_u32 s56, s56, 147472
  v_mov_b32 v5, s56
  s_mov_b32 s62, 4000000
L_pair:
  ds_read_b32 v6, v5
  s_sub_u32 s62, s62, 1
  s_cmp_eq_u32 s62, 0
  s_cbranch_scc1 L_paired
  s_waitcnt lgkmcnt(0)
  v_readfirstlane_b32 s56, v6
  s_cmp_eq_u32 s56, 1
  s_cbranch_scc0 L_pair
L_paired:
  s_waitcnt lgkmcnt(0)
  s_add_u32 s56, s60, 0
  buffer_load_dwordx4 v[20:23], v252, s[36:39], s56 offen sc1
  buffer_load_dwordx4 v[24:27], v252, s[36:39], s56 offen offset:2048 sc1
  s_add_u32 s56, s56, 4096
  buffer_load_dwordx4 v[28:31], v252, s[36:39], s56 offen sc1
  buffer_load_dwordx4 v[32:35], v252, s[36:39], s56 offen offset:2048 sc1
  s_add_u32 s56, s56, 4096
  buffer_load_dwordx4 v[36:39], v252, s[36:39], s56 offen sc1
  buffer_load_dwordx4 v[40:43], v252, s[36:39], s56 offen offset:2048 sc1
  s_add_u32 s56, s60, 114688
  buffer_load_dwordx4 v[44:47], v252, s[36:39], s56 offen sc1
  buffer_load_dwordx4 v[48:51], v252, s[36:39], s56 offen offset:2048 sc1
  s_add_u32 s56, s56, 4096
  buffer_load_dwordx4 v[52:55], v252, s[36:39], s56 offen sc1
  buffer_load_dwordx4 v[56:59], v252, s[36:39], s56 offen offset:2048 sc1
  s_add_u32 s56, s56, 4096
  buffer_load_dwordx4 v[60:63], v252, s[36:39], s56 offen sc1
  buffer_load_dwordx4 v[64:67], v252, s[36:39], s56 offen offset:2048 sc1
  v_and_b32 v5, 15, v2
  v_lshrrev_b32 v6, 4, v2
  v_xor_b32 v6, v6, v5
  v_lshlrev_b32 v5, 8, v5
  s_add_u32 s56, s63, 32768
  v_add_u32 v5, s56, v5
  v_xor_b32 v7, 0, v6
  v_lshl_add_u32 v10, v7, 4, v5
  v_xor_b32 v7, 4, v6
  v_lshl_add_u32 v11, v7, 4, v5
  v_xor_b32 v7, 8, v6
  v_lshl_add_u32 v12, v7, 4, v5
  v_xor_b32 v7, 12, v6
  v_lshl_add_u32 v13, v7, 4, v5
  s_waitcnt vmcnt(11)
  v_mfma_f32_16x16x32_bf16 v[68:71], v[148:151], v[20:23], 0
  v_mfma_f32_16x16x32_bf16 v[72:75], v[152:155], v[20:23], 0
  v_mfma_f32_16x16x32_bf16 v[76:79], v[156:159], v[20:23], 0
  v_mfma_f32_16x16x32_bf16 v[80:83], v[160:163], v[20:23], 0
  s_waitcnt vmcnt(10)
  v_mfma_f32_16x16x32_bf16 v[68:71], v[164:167], v[24:27], v[68:71]
  v_mfma_f32_16x16x32_bf16 v[72:75], v[168:171], v[24:27], v[72:75]
  v_mfma_f32_16x16x32_bf16 v[76:79], v[172:175], v[24:27], v[76:79]
  v_mfma_f32_16x16x32_bf16 v[80:83], v[176:179], v[24:27], v[80:83]
  s_waitcnt vmcnt(9)
  v_mfma_f32_16x16x32_bf16 v[68:71], v[180:183], v[28:31], v[68:71]
  v_mfma_f32_16x16x32_bf16 v[72:75], v[184:187], v[28:31], v[72:75]
  v_mfma_f32_16x16x32_bf16 v[76:79], v[188:191], v[28:31], v[76:79]
  v_mfma_f32_16x16x32_bf16 v[80:83], v[192:195], v[28:31], v[80:83]
  s_waitcnt vmcnt(8)
  v_mfma_f32_16x16x32_bf16 v[68:71], v[196:199], v[32:35], v[68:71]
  v_mfma_f32_16x16x32_bf16 v[72:75], v[200:203], v[32:35], v[72:75]
  v_mfma_f32_16x16x32_bf16 v[76:79], v[204:207], v[32:35], v[76:79]
  v_mfma_f32_16x16x32_bf16 v[80:83], v[208:211], v[32:35], v[80:83]
  s_waitcnt vmcnt(7)
  v_mfma_f32_16x16x32_bf16 v[68:71], v[212:215], v[36:39], v[68:71]
  v_mfma_f32_16x16x32_bf16 v[72:75], v[216:219], v[36:39], v[72:75]
  v_mfma_f32_16x16x32_bf16 v[76:79], v[220:223], v[36:39], v[76:79]
  v_mfma_f32_16x16x32_bf16 v[80:83], v[224:227], v[36:39], v[80:83]
  s_waitcnt vmcnt(6)
  v_mfma_f32_16x16x32_bf16 v[68:71], v[228:231], v[40:43], v[68:71]
  v_mfma_f32_16x16x32_bf16 v[72:75], v[232:235], v[40:43], v[72:75]
  v_mfma_f32_16x16x32_bf16 v[76:79], v[236:239], v[40:43], v[76:79]
  v_mfma_f32_16x16x32_bf16 v[80:83], v[240:243], v[40:43], v[80:83]
  s_waitcnt vmcnt(5)
  v_mfma_f32_16x16x32_bf16 v[84:87], v[148:151], v[44:47], 0
  v_mfma_f32_16x16x32_bf16 v[88:91], v[152:155], v[44:47], 0
  v_mfma_f32_16x16x32_bf16 v[92:95], v[156:159], v[44:47], 0
  v_mfma_f32_16x16x32_bf16 v[96:99], v[160:163], v[44:47], 0
  s_waitcnt vmcnt(4)
  v_mfma_f32_16x16x32_bf16 v[84:87], v[164:167], v[48:51], v[84:87]
  v_mfma_f32_16x16x32_bf16 v[88:91], v[168:171], v[48:51], v[88:91]
  v_mfma_f32_16x16x32_bf16 v[92:95], v[172:175], v[48:51], v[92:95]
  v_mfma_f32_16x16x32_bf16 v[96:99], v[176:179], v[48:51], v[96:99]
  ds_write_b128 v10, v[68:71]
  ds_write_b128 v11, v[72:75]
  ds_write_b128 v12, v[76:79]
  ds_write_b128 v13, v[80:83]
  s_waitcnt vmcnt(3)
  v_mfma_f32_16x16x32_bf16 v[84:87], v[180:183], v[52:55], v[84:87]
  v_mfma_f32_16x16x32_bf16 v[88:91], v[184:187], v[52:55], v[88:91]
  v_mfma_f32_16x16x32_bf16 v[92:95], v[188:191], v[52:55], v[92:95]
  v_mfma_f32_16x16x32_bf16 v[96:99], v[192:195], v[52:55], v[96:99]
  s_waitcnt vmcnt(2)
  v_mfma_f32_16x16x32_bf16 v[84:87], v[196:199], v[56:59], v[84:87]
  v_mfma_f32_16x16x32_bf16 v[88:91], v[200:203], v[56:59], v[88:91]
  v_mfma_f32_16x16x32_bf16 v[92:95], v[204:207], v[56:59], v[92:95]
  v_mfma_f32_16x16x32_bf16 v[96:99], v[208:211], v[56:59], v[96:99]
  s_waitcnt vmcnt(1)
  v_mfma_f32_16x16x32_bf16 v[84:87], v[212:215], v[60:63], v[84:87]
  v_mfma_f32_16x16x32_bf16 v[88:91], v[216:219], v[60:63], v[88:91]
  v_mfma_f32_16x16x32_bf16 v[92:95], v[220:223], v[60:63], v[92:95]
  v_mfma_f32_16x16x32_bf16 v[96:99], v[224:227], v[60:63], v[96:99]
  s_waitcnt vmcnt(0)
  v_mfma_f32_16x16x32_bf16 v[84:87], v[228:231], v[64:67], v[84:87]
  v_mfma_f32_16x16x32_bf16 v[88:91], v[232:235], v[64:67], v[88:91]
  v_mfma_f32_16x16x32_bf16 v[92:95], v[236:239], v[64:67], v[92:95]
  v_mfma_f32_16x16x32_bf16 v[96:99], v[240:243], v[64:67], v[96:99]
  s_nop 7
  s_nop 1
  ds_write_b128 v10, v[84:87] offset:4096
  ds_write_b128 v11, v[88:91] offset:4096
  ds_write_b128 v12, v[92:95] offset:4096
  ds_write_b128 v13, v[96:99] offset:4096
  s_waitcnt lgkmcnt(0)
  s_branch L_final
L_final:
  s_barrier
  v_lshrrev_b32 v13, 4, v0
  v_and_b32 v14, 15, v0
  v_and_b32 v15, 15, v13
  v_xor_b32 v15, v15, v14
  v_lshlrev_b32 v15, 4, v15
  v_lshl_add_u32 v15, v13, 8, v15
  v_add_u32 v15, 32768, v15
  v_add_u32 v12, 65536, v15
  ds_read_b128 v[16:19], v15 offset:0
  ds_read_b128 v[20:23], v15 offset:8192
  ds_read_b128 v[24:27], v15 offset:16384
  ds_read_b128 v[28:31], v15 offset:24576
  ds_read_b128 v[32:35], v12 offset:0
  ds_read_b128 v[36:39], v12 offset:8192
  ds_read_b128 v[40:43], v12 offset:16384
  ds_read_b128 v[44:47], v12 offset:24576
  s_lshr_b32 s56, s3, 1
  s_lshl_b32 s56, s56, 6
  s_and_b32 s57, s3, 1
  s_lshl_b32 s57, s57, 4
  s_add_u32 s56, s56, s57
  s_lshl_b32 s56, s56, 10
  s_lshl_b32 s57, s5, 7
  s_add_u32 s56, s56, s57
  v_lshrrev_b32 v5, 4, v13
  v_and_b32 v6, 15, v13
  v_lshl_add_u32 v6, v5, 5, v6
  v_lshlrev_b32 v6, 10, v6
  v_lshl_add_u32 v6, v14, 3, v6
  s_waitcnt lgkmcnt(4)
  v_pk_add_f32 v[16:17], v[16:17], v[20:21]
  v_pk_add_f32 v[18:19], v[18:19], v[22:23]
  v_pk_add_f32 v[24:25], v[24:25], v[28:29]
  v_pk_add_f32 v[26:27], v[26:27], v[30:31]
  v_pk_add_f32 v[16:17], v[16:17], v[24:25]
  v_pk_add_f32 v[18:19], v[18:19], v[26:27]
  s_waitcnt lgkmcnt(0)
  v_pk_add_f32 v[32:33], v[32:33], v[36:37]
  v_pk_add_f32 v[34:35], v[34:35], v[38:39]
  v_pk_add_f32 v[40:41], v[40:41], v[44:45]
  v_pk_add_f32 v[42:43], v[42:43], v[46:47]
  v_pk_add_f32 v[32:33], v[32:33], v[40:41]
  v_pk_add_f32 v[34:35], v[34:35], v[42:43]
  v_pk_add_f32 v[16:17], v[16:17], v[32:33]
  v_pk_add_f32 v[18:19], v[18:19], v[34:35]
  v_cvt_pk_bf16_f32 v16, v16, v17
  v_cvt_pk_bf16_f32 v17, v18, v19
  buffer_store_dwordx2 v[16:17], v6, s[40:43], s56 offen
L_end:
  s_endpgm
.section .rodata,"a"
.p2align 6
.amdhsa_kernel standalone__glu_gated_swiglu__sampling_kernel
  .amdhsa_next_free_vgpr 256
  .amdhsa_next_free_sgpr 102
  .amdhsa_accum_offset 256
  .amdhsa_group_segment_fixed_size 0
  .amdhsa_kernarg_size 56
  .amdhsa_user_sgpr_count 2
  .amdhsa_user_sgpr_kernarg_segment_ptr 1
  .amdhsa_system_sgpr_workgroup_id_x 1
.end_amdhsa_kernel
```
